```python
import torch

def _softmax(x, axis=-1):
    return torch.softmax(x, dim=axis)
def _gelu(x):
    return torch.nn.functional.gelu(x, approximate="tanh")
def _silu(x):
    return torch.nn.functional.silu(x)
def _sigmoid(x):
    return torch.sigmoid(x)
def _layernorm(x, axis=-1, eps=1e-5):
    m = x.mean(dim=axis, keepdim=True)
    v = x.var(dim=axis, keepdim=True, unbiased=False)
    return (x - m) / torch.sqrt(v + eps)
def _scatter_add(tgt, idx, src, axis=0):
    return tgt.clone().index_add_(axis, idx, src)
def _segment_sum(src, seg, n):
    out = torch.zeros((n,) + src.shape[1:], dtype=src.dtype)
    return out.index_add_(0, seg, src)
def _pad(x, pw):
    flat = tuple(v for pair in reversed(pw) for v in pair)
    return torch.nn.functional.pad(x, flat)

kernel_name = 'gated_mix__spectral_gfnet__spectral_gfnet__prompt'

def setup_inputs():

    _w = (lambda a: (lambda t: t.to(torch.bfloat16) if t.is_floating_point() else t)(torch.as_tensor(a)))
    def _A_setup():
        B, S, D = 1, 2048, 1024
        Df = D // 2 + 1
        return {
            "x": _w((lambda *s: torch.randn(*s, dtype=torch.bfloat16) * 0.05)(B, S, D)),
            "w_r": _w((lambda *s: torch.randn(*s, dtype=torch.bfloat16) * 0.05)(S, Df) * 0.02),
            "w_i": _w((lambda *s: torch.randn(*s, dtype=torch.bfloat16) * 0.05)(S, Df) * 0.02),
        }
    _A_in = _A_setup()

    def _B_setup():
        B, S, D = 1, 2048, 1024
        Df = D // 2 + 1
        return {
            "x": _w((lambda *s: torch.randn(*s, dtype=torch.bfloat16) * 0.05)(B, S, D)),
            "w_r": _w((lambda *s: torch.randn(*s, dtype=torch.bfloat16) * 0.05)(S, Df) * 0.02),
            "w_i": _w((lambda *s: torch.randn(*s, dtype=torch.bfloat16) * 0.05)(S, Df) * 0.02),
        }
    _B_in = _B_setup()

    return {
        "A_x": _A_in["x"],
        "A_w_r": _A_in["w_r"],
        "A_w_i": _A_in["w_i"],
        "B_x": _B_in["x"],
        "B_w_r": _B_in["w_r"],
        "B_w_i": _B_in["w_i"],
        "gate_w": _w((lambda *s: torch.randn(*s, dtype=torch.bfloat16) * 0.05)(1024) * 16.0),
    }

def reference(A_x, A_w_r, A_w_i, B_x, B_w_r, B_w_i, gate_w):
    def _A_ref(x, w_r, w_i):
        B, S, D = x.shape
        X = (lambda x, axes=(-2,-1): torch.fft.rfft2(x.float(), dim=axes))(x, axes=(-2, -1))
        W = w_r + 1j * w_i
        X = X * W
        y = (lambda x, s, axes=(-2,-1): torch.fft.irfft2(x, s=s, dim=axes).to(torch.bfloat16))(X, (S, D), axes=(-2, -1))
        return y

    def _B_ref(x, w_r, w_i):
        B, S, D = x.shape
        X = (lambda x, axes=(-2,-1): torch.fft.rfft2(x.float(), dim=axes))(x, axes=(-2, -1))
        W = w_r + 1j * w_i
        X = X * W
        y = (lambda x, s, axes=(-2,-1): torch.fft.irfft2(x, s=s, dim=axes).to(torch.bfloat16))(X, (S, D), axes=(-2, -1))
        return y

    x = A_x
    g = _sigmoid((x * gate_w).sum(-1, keepdims=True))
    a = _A_ref(x, A_w_r, A_w_i)
    b = _B_ref(x, B_w_r, B_w_i)
    return g * a + (1 - g) * b
```

```asm
; @launch grid=(256,1,1) block=(512,1,1) lds=50304
.amdgcn_target "amdgcn-amd-amdhsa--gfx950"
.text
.globl gated_mix__spectral_gfnet__spectral_gfnet__prompt_kernel
.p2align 8
.type gated_mix__spectral_gfnet__spectral_gfnet__prompt_kernel,@function
gated_mix__spectral_gfnet__spectral_gfnet__prompt_kernel:
    s_cmp_gt_u32 s2, 255
    s_cbranch_scc1 L_end
    s_load_dwordx16 s[4:19], s[0:1], 0
    s_load_dwordx4 s[20:23], s[0:1], 64
    s_memrealtime s[64:65]
    s_getpc_b64 s[92:93]
L_pc:
    s_mov_b32 s94, L_codeend - L_pc
    s_mov_b32 s95, 0x00020000
    v_lshlrev_b32 v7, 6, v0
    buffer_load_dword v6, v7, s[92:95], 0 offen
    v_lshrrev_b32 v1, 6, v0
    s_nop 0
    v_readfirstlane_b32 s60, v1
    v_and_b32 v1, 63, v0
    v_and_b32 v2, 15, v0
    v_bfe_u32 v3, v0, 4, 2
    v_mov_b32 v4, 0
    v_mov_b32 v5, 0
    s_and_b32 s61, s60, 1
    s_lshr_b32 s62, s60, 1
    s_and_b32 s66, s2, 7
    s_lshr_b32 s67, s2, 3
    s_lshl_b32 s63, s66, 5
    s_add_u32 s63, s63, s67
    s_lshl_b32 s71, s61, 6
    v_lshlrev_b32 v58, 4, v1
    v_xor_b32 v58, s71, v58
    s_lshl_b32 s68, s61, 2
    s_add_u32 s68, s68, s62
    s_lshl_b32 s69, s68, 8
    s_add_u32 s69, s69, s63
    s_lshl_b32 s69, s69, 11
    s_lshl_b32 s70, s60, 11
    s_mov_b32 m0, s70
    s_lshl_b32 s72, s2, 3
    s_or_b32 s72, s72, s60
    s_cmp_eq_u32 s72, 0
    s_cselect_b64 s[84:85], 1, 0
    v_mul_u32_u24 v59, 8208, v3
    v_lshl_add_u32 v59, v2, 6, v59
    s_lshl_b32 s72, s67, 1
    s_lshr_b32 s73, s60, 2
    s_add_u32 s72, s72, s73
    s_lshl_b32 s72, s72, 5
    s_add_u32 s72, s72, s66
    s_mul_i32 s72, s72, 1026
    v_cmp_eq_u32 s[80:81], 0, v2
    s_waitcnt lgkmcnt(0)
    s_mov_b32 s24, s4
    s_mov_b32 s25, s5
    s_mov_b32 s26, 0x400000
    s_mov_b32 s27, 0x00020000
    buffer_load_dwordx4 v58, s[24:27], s69 offen  lds
    buffer_load_dwordx4 v58, s[24:27], s69 offen offset:1024  lds
    s_mov_b32 s40, s20
    s_mov_b32 s41, s21
    s_mov_b32 s42, 0x100
    s_mov_b32 s43, 0x00020000
    s_or_b32 s64, s64, 1
    v_mov_b32 v7, s64
    s_mov_b64 exec, s[84:85]
    buffer_store_dword v7, v4, s[40:43], 0 offen sc0 sc1
    s_bitcmp1_b32 s60, 0
    s_cselect_b64 s[76:77], s[8:9], s[6:7]
    s_cselect_b64 s[74:75], s[14:15], s[12:13]
    s_bitcmp1_b32 s60, 1
    s_cselect_b64 s[76:77], s[74:75], s[76:77]
    s_mov_b32 s78, 0x201000
    s_mov_b32 s79, 0x00020000
    s_mov_b64 exec, s[80:81]
    buffer_load_ushort v72, v59, s[76:79], s72 offen offset:1024
    s_mov_b64 exec, -1
    s_mov_b32 s44, s6
    s_mov_b32 s45, s7
    s_mov_b32 s46, 0x201000
    s_mov_b32 s47, 0x00020000
    s_mov_b32 s48, s8
    s_mov_b32 s49, s9
    s_mov_b32 s50, 0x201000
    s_mov_b32 s51, 0x00020000
    s_mov_b32 s52, s12
    s_mov_b32 s53, s13
    s_mov_b32 s54, 0x201000
    s_mov_b32 s55, 0x00020000
    s_mov_b32 s56, s14
    s_mov_b32 s57, s15
    s_mov_b32 s58, 0x201000
    s_mov_b32 s59, 0x00020000
    v_mul_u32_u24 v7, 525312, v3
    v_lshl_add_u32 v7, v2, 1, v7
    s_mul_i32 s64, s66, 1026
    s_lshl_b32 s65, s67, 5
    s_add_u32 s64, s64, s65
    s_mul_i32 s4, s60, 16416
    s_add_u32 s4, s4, s64
    s_add_u32 s5, s4, 131328
    s_add_u32 s6, s4, 262656
    s_add_u32 s7, s4, 393984
    s_add_u32 s8, s4, 8208
    s_add_u32 s9, s4, 139536
    s_add_u32 s10, s4, 270864
    s_add_u32 s11, s4, 402192
    s_mov_b32 s32, s22
    s_mov_b32 s33, s23
    s_mov_b32 s34, 0xc80000
    s_mov_b32 s35, 0x00020000
    s_mov_b32 s36, s18
    s_mov_b32 s37, s19
    s_mov_b32 s38, 0x400000
    s_mov_b32 s39, 0x00020000
    v_lshlrev_b32 v92, 20, v3
    v_lshl_add_u32 v92, v2, 4, v92
    s_lshl_b32 s12, s63, 11
    s_lshl_b32 s13, s60, 8
    s_add_u32 s12, s12, s13
    s_add_u32 s14, s12, 524288
    s_lshl_b32 s13, s63, 6
    s_add_u32 s13, s13, 4194304
    s_mov_b32 s28, s16
    s_mov_b32 s29, s17
    s_mov_b32 s30, 0x800
    s_mov_b32 s31, 0x00020000
    v_lshl_add_u32 v80, s61, 4, v2
    v_cvt_f32_u32 v81, v80
    v_lshlrev_b32 v82, 3, v3
    v_cvt_f32_u32 v82, v82
    v_mul_f32 v81, 0x3d000000, v81
    v_mul_f32 v82, v82, v81
    v_cos_f32 v84, v82
    v_sin_f32 v85, v82
    v_mul_f32 v32, 0x3d000000, v82
    v_cvt_pk_bf16_f32 v8, v84, v85
    v_cvt_pk_bf16_f32 v16, -v85, v84
    v_fmamk_f32 v83, v81, 0x3f800000, v82
    buffer_load_short_d16_hi v96, v7, s[44:47], s4 offen
    v_cos_f32 v86, v83
    v_sin_f32 v87, v83
    v_mul_f32 v33, 0x3d000000, v83
    v_cvt_pk_bf16_f32 v12, v86, v87
    v_cvt_pk_bf16_f32 v20, -v87, v86
    v_fmamk_f32 v83, v81, 0x40000000, v82
    v_cos_f32 v84, v83
    v_sin_f32 v85, v83
    v_mul_f32 v34, 0x3d000000, v83
    v_cvt_pk_bf16_f32 v9, v84, v85
    v_cvt_pk_bf16_f32 v17, -v85, v84
    v_fmamk_f32 v83, v81, 0x40400000, v82
    v_cos_f32 v86, v83
    v_sin_f32 v87, v83
    v_mul_f32 v35, 0x3d000000, v83
    v_cvt_pk_bf16_f32 v13, v86, v87
    buffer_load_short_d16_hi v104, v7, s[48:51], s4 offen
    v_cvt_pk_bf16_f32 v21, -v87, v86
    v_fmamk_f32 v83, v81, 0x40800000, v82
    v_cos_f32 v84, v83
    v_sin_f32 v85, v83
    v_mul_f32 v36, 0x3d000000, v83
    v_cvt_pk_bf16_f32 v10, v84, v85
    v_cvt_pk_bf16_f32 v18, -v85, v84
    v_fmamk_f32 v83, v81, 0x40a00000, v82
    v_cos_f32 v86, v83
    v_sin_f32 v87, v83
    v_mul_f32 v37, 0x3d000000, v83
    v_cvt_pk_bf16_f32 v14, v86, v87
    v_cvt_pk_bf16_f32 v22, -v87, v86
    v_fmamk_f32 v83, v81, 0x40c00000, v82
    v_cos_f32 v84, v83
    v_sin_f32 v85, v83
    buffer_load_short_d16_hi v97, v7, s[44:47], s5 offen
    v_mul_f32 v38, 0x3d000000, v83
    v_cvt_pk_bf16_f32 v11, v84, v85
    v_cvt_pk_bf16_f32 v19, -v85, v84
    v_fmamk_f32 v83, v81, 0x40e00000, v82
    v_cos_f32 v86, v83
    v_sin_f32 v87, v83
    v_mul_f32 v39, 0x3d000000, v83
    v_cvt_pk_bf16_f32 v15, v86, v87
    v_cvt_pk_bf16_f32 v23, -v87, v86
    v_cos_f32 v24, v32
    v_sin_f32 v32, v32
    v_cos_f32 v25, v33
    v_sin_f32 v33, v33
    v_cos_f32 v26, v34
    v_sin_f32 v34, v34
    v_cos_f32 v27, v35
    buffer_load_short_d16_hi v105, v7, s[48:51], s5 offen
    v_sin_f32 v35, v35
    v_cos_f32 v28, v36
    v_sin_f32 v36, v36
    v_cos_f32 v29, v37
    v_sin_f32 v37, v37
    v_cos_f32 v30, v38
    v_sin_f32 v38, v38
    v_cos_f32 v31, v39
    v_sin_f32 v39, v39
    s_cmp_eq_u32 s61, 0
    s_cselect_b32 s90, 1.0, -1.0
    s_mov_b32 s91, s90
    s_cselect_b64 s[86:87], 1, 0
    v_and_b32 v78, 3, v2
    v_lshlrev_b32 v78, 4, v78
    v_bfe_u32 v80, v2, 2, 1
    buffer_load_short_d16_hi v98, v7, s[44:47], s6 offen
    v_mul_u32_u24 v80, 2112, v80
    v_lshrrev_b32 v81, 3, v2
    v_lshl_add_u32 v78, v81, 7, v78
    v_lshl_add_u32 v78, v3, 9, v78
    s_lshl_b32 s73, s62, 12
    v_add3_u32 v78, v78, v80, s73
    v_xor_b32 v79, 64, v78
    s_cmp_eq_u32 s60, 0
    s_cselect_b64 s[84:85], 1, 0
    buffer_load_short_d16_hi v106, v7, s[48:51], s6 offen
    buffer_load_short_d16_hi v99, v7, s[44:47], s7 offen
    buffer_load_short_d16_hi v107, v7, s[48:51], s7 offen
    s_waitcnt vmcnt(8)
    s_barrier
    ds_read_b64_tr_b16 v[40:41], v78 offset:0
    ds_read_b64_tr_b16 v[42:43], v78 offset:256
    ds_read_b64_tr_b16 v[44:45], v79 offset:0
    ds_read_b64_tr_b16 v[46:47], v79 offset:256
    ds_read_b64_tr_b16 v[48:49], v78 offset:8
    ds_read_b64_tr_b16 v[50:51], v78 offset:264
    ds_read_b64_tr_b16 v[52:53], v79 offset:8
    ds_read_b64_tr_b16 v[54:55], v79 offset:264
    s_mov_b64 exec, s[84:85]
    buffer_load_dword v5, v4, s[40:43], 0 offen sc0 sc1
    s_mov_b64 exec, -1
    v_lshlrev_b32 v74, 2, v1
    s_lshl_b32 s64, s2, 6
    s_add_u32 s65, s64, 0x430000
    s_add_u32 s64, s64, 0x420000
    s_cmp_eq_u32 s60, 6
    s_cselect_b32 s65, s64, s65
    s_cmp_eq_u32 s60, 7
    s_cselect_b32 s65, s13, s65
    s_mul_i32 s64, s2, 256
    s_add_u32 s64, s64, 0x450000
    s_mov_b32 s92, 0xffffffff
    s_mov_b32 s93, 0xffffffff
    s_cmp_eq_u32 s60, 5
    s_cselect_b32 s65, s64, s65
    s_cselect_b64 s[92:93], s[92:93], 0xffff
    s_add_u32 s64, s60, -1
    s_cmp_lt_u32 s64, 4
    s_cselect_b64 exec, 0, s[92:93]
    buffer_store_dword v4, v74, s[32:35], s65 offen sc1
    s_mov_b64 exec, -1
    s_waitcnt lgkmcnt(6)
    v_mfma_f32_16x16x32_bf16 v[56:59], v[40:43], v[8:11], 0
    s_lshr_b32 s82, s60, 2
    s_lshl_b32 s82, s82, 5
    s_and_b32 s83, s60, 3
    s_lshl_b32 s83, s83, 1
    s_add_u32 s82, s82, s83
    v_lshl_add_u32 v73, v3, 3, s82
    s_lshl_b32 s82, s2, 6
    v_mfma_f32_16x16x32_bf16 v[60:63], v[40:43], v[16:19], 0
    s_add_u32 s82, s82, 0x420000
    s_mul_i32 s73, s62, 4496
    s_add_u32 s73, s73, 16384
    s_lshl_b32 s74, s61, 7
    v_lshlrev_b32 v80, 5, v3
    v_add_u32 v80, s74, v80
    v_mul_u32_u24 v81, 264, v2
    s_waitcnt lgkmcnt(4)
    v_mfma_f32_16x16x32_bf16 v[56:59], v[44:47], v[12:15], v[56:59]
    v_add3_u32 v88, v80, v81, s73
    s_add_u32 s75, s73, 4196
    v_add_u32 v81, v80, v81
    v_sub_u32 v89, s75, v81
    v_cmp_eq_u32 vcc, 0, v80
    v_mul_u32_u24 v91, 4496, v3
    v_add_u32 v93, 20608, v91
    v_mfma_f32_16x16x32_bf16 v[60:63], v[44:47], v[20:23], v[60:63]
    v_cndmask_b32 v81, 24, 32, vcc
    v_add_u32 v90, v89, v81
    v_lshrrev_b32 v80, 3, v2
    v_mul_u32_u24 v80, 264, v80
    v_and_b32 v81, 7, v2
    v_lshl_add_u32 v80, v81, 5, v80
    s_mul_i32 s73, s60, 528
    s_waitcnt lgkmcnt(2)
    v_mfma_f32_16x16x32_bf16 v[64:67], v[48:51], v[8:11], 0
    s_add_u32 s73, s73, 16384
    v_add3_u32 v91, v91, v80, s73
    v_lshrrev_b32 v80, 1, v2
    v_lshl_add_u32 v81, v3, 8, s63
    v_mul_u32_u24 v81, v81, v80
    v_and_b32 v82, 1, v2
    v_lshl_add_u32 v81, v82, 9, v81
    v_mfma_f32_16x16x32_bf16 v[68:71], v[48:51], v[16:19], 0
    v_and_b32 v82, 1, v80
    v_lshlrev_b32 v82, 9, v82
    v_sub_u32 v82, 256, v82
    v_add_u32 v83, v81, v82
    v_sub_u32 v84, v81, v82
    v_cvt_f32_i32 v83, v83
    v_cvt_f32_i32 v84, v84
    s_waitcnt lgkmcnt(0)
    v_mfma_f32_16x16x32_bf16 v[64:67], v[52:55], v[12:15], v[64:67]
    v_mul_f32 v83, 0x3a000000, v83
    v_mul_f32 v84, 0x3a000000, v84
    v_cos_f32 v80, v83
    v_sin_f32 v81, v83
    v_cos_f32 v82, v84
    v_sin_f32 v83, v84
    v_cvt_pk_bf16_f32 v94, v80, v81
    v_mfma_f32_16x16x32_bf16 v[68:71], v[52:55], v[20:23], v[68:71]
    v_cvt_pk_bf16_f32 v95, v82, -v83
    v_cmp_gt_u32 vcc, 2, v2
    s_cmp_eq_u32 s60, 7
    s_nop 2
    s_cselect_b64 s[96:97], vcc, 0
    s_mov_b64 exec, s[80:81]
    ds_write_b16 v73, v72 offset:49216
    s_mov_b64 exec, -1
    v_pk_mul_f32 v[80:81], v[60:61], v[32:33]
    v_pk_mul_f32 v[82:83], v[56:57], v[32:33]
    v_pk_fma_f32 v[80:81], v[56:57], v[24:25], v[80:81]
    v_pk_fma_f32 v[82:83], v[60:61], v[24:25], v[82:83] neg_lo:[0,0,1] neg_hi:[0,0,1]
    v_cvt_pk_bf16_f32 v72, v80, v82
    v_cvt_pk_bf16_f32 v76, v81, v83
    v_pk_mul_f32 v[84:85], v[62:63], v[34:35]
    v_pk_mul_f32 v[86:87], v[58:59], v[34:35]
    v_pk_fma_f32 v[84:85], v[58:59], v[26:27], v[84:85]
    v_pk_fma_f32 v[86:87], v[62:63], v[26:27], v[86:87] neg_lo:[0,0,1] neg_hi:[0,0,1]
    v_cvt_pk_bf16_f32 v73, v84, v86
    v_cvt_pk_bf16_f32 v77, v85, v87
    v_pk_mul_f32 v[80:81], v[68:69], v[36:37]
    v_pk_mul_f32 v[82:83], v[64:65], v[36:37]
    v_pk_fma_f32 v[80:81], v[64:65], v[28:29], v[80:81]
    v_pk_fma_f32 v[82:83], v[68:69], v[28:29], v[82:83] neg_lo:[0,0,1] neg_hi:[0,0,1]
    v_cvt_pk_bf16_f32 v74, v80, v82
    v_cvt_pk_bf16_f32 v78, v81, v83
    v_pk_mul_f32 v[84:85], v[70:71], v[38:39]
    v_pk_mul_f32 v[86:87], v[66:67], v[38:39]
    v_pk_fma_f32 v[84:85], v[66:67], v[30:31], v[84:85]
    v_pk_fma_f32 v[86:87], v[70:71], v[30:31], v[86:87] neg_lo:[0,0,1] neg_hi:[0,0,1]
    v_cvt_pk_bf16_f32 v75, v84, v86
    v_cvt_pk_bf16_f32 v79, v85, v87
    s_nop 0
    v_mfma_f32_16x16x32_bf16 v[40:43], v[72:75], v[8:11], 0
    v_mfma_f32_16x16x32_bf16 v[48:51], v[76:79], v[12:15], 0
    v_mfma_f32_16x16x32_bf16 v[44:47], v[72:75], v[16:19], 0
    v_mfma_f32_16x16x32_bf16 v[52:55], v[76:79], v[20:23], 0
    v_lshlrev_b32 v35, 5, v1
    v_xor_b32 v32, s71, v35
    v_add_u32 v35, s70, v35
    v_lshlrev_b32 v33, 5, v2
    v_lshl_add_u32 v33, v3, 3, v33
    v_lshlrev_b32 v34, 4, v1
    v_and_b32 v34, 48, v34
    v_pk_fma_f32 v[56:57], v[48:49], s[90:91], v[40:41]
    v_pk_fma_f32 v[64:65], v[48:49], s[90:91], v[40:41] neg_lo:[1,0,0] neg_hi:[1,0,0]
    v_pk_fma_f32 v[58:59], v[50:51], s[90:91], v[42:43]
    v_pk_fma_f32 v[66:67], v[50:51], s[90:91], v[42:43] neg_lo:[1,0,0] neg_hi:[1,0,0]
    v_pk_fma_f32 v[60:61], v[52:53], s[90:91], v[44:45]
    v_pk_fma_f32 v[68:69], v[52:53], s[90:91], v[44:45] neg_lo:[1,0,0] neg_hi:[1,0,0]
    v_pk_fma_f32 v[62:63], v[54:55], s[90:91], v[46:47]
    v_pk_fma_f32 v[70:71], v[54:55], s[90:91], v[46:47] neg_lo:[1,0,0] neg_hi:[1,0,0]
    v_cvt_pk_bf16_f32 v72, v56, v60
    v_cvt_pk_bf16_f32 v73, v57, v61
    ds_write2_b32 v88, v72, v73 offset0:0 offset1:2
    v_cvt_pk_bf16_f32 v74, v58, v62
    v_cvt_pk_bf16_f32 v75, v59, v63
    ds_write2_b32 v88, v74, v75 offset0:4 offset1:6
    v_cvt_pk_bf16_f32 v76, v64, v68
    ds_write_b32 v90, v76
    v_cvt_pk_bf16_f32 v77, v65, v69
    ds_write_b32 v89, v77 offset:16
    v_cvt_pk_bf16_f32 v78, v66, v70
    v_cvt_pk_bf16_f32 v79, v67, v71
    ds_write2_b32 v89, v78, v79 offset0:2 offset1:0
    buffer_load_dwordx4 v[24:27], v32, s[28:31], 0 offen
    buffer_load_dwordx4 v[28:31], v32, s[28:31], 0 offen offset:16
    s_mov_b64 exec, s[86:87]
    ds_write_b32 v88, v72 offset:4
    ds_write_b32 v88, v76 offset:4224
    s_mov_b64 exec, -1
    s_waitcnt lgkmcnt(0)
    s_barrier
    ds_read_b64 v[64:65], v91 offset:0
    ds_read_b64 v[66:67], v91 offset:8
    ds_read_b64 v[68:69], v91 offset:16
    ds_read_b64 v[70:71], v91 offset:24
    ds_read_b64 v[72:73], v93
    ds_read_b128 v[36:39], v34 offset:49216
    ds_read_b128 v[8:11], v35
    ds_read_b128 v[12:15], v35 offset:16
    s_waitcnt lgkmcnt(7)
    v_mfma_f32_16x16x16_bf16 v[40:43], v[94:95], v[64:65], 0
    s_waitcnt lgkmcnt(6)
    v_mfma_f32_16x16x16_bf16 v[44:47], v[94:95], v[66:67], 0
    s_waitcnt lgkmcnt(5)
    v_mfma_f32_16x16x16_bf16 v[48:51], v[94:95], v[68:69], 0
    s_waitcnt lgkmcnt(4)
    v_mfma_f32_16x16x16_bf16 v[52:55], v[94:95], v[70:71], 0
    s_waitcnt lgkmcnt(3)
    v_mfma_f32_16x16x16_bf16 v[76:79], v[94:95], v[72:73], 0
    v_cvt_pk_bf16_f32 v56, v40, v41
    s_nop 0
    v_cvt_pk_bf16_f32 v57, v44, v45
    s_nop 0
    v_cvt_pk_bf16_f32 v58, v48, v49
    s_nop 0
    v_cvt_pk_bf16_f32 v59, v52, v53
    buffer_store_dwordx4 v[56:59], v92, s[36:39], s12 offen sc1
    v_cvt_pk_bf16_f32 v60, v42, v43
    v_cvt_pk_bf16_f32 v61, v46, v47
    v_cvt_pk_bf16_f32 v62, v50, v51
    v_cvt_pk_bf16_f32 v63, v54, v55
    buffer_store_dwordx4 v[60:63], v92, s[36:39], s14 offen sc1
    v_cvt_pk_bf16_f32 v82, v76, v77
    v_cvt_pk_bf16_f32 v83, v78, v79
    s_waitcnt vmcnt(2)
    s_mov_b64 exec, s[96:97]
    buffer_store_dwordx2 v[82:83], v33, s[32:35], s13 offen sc1
    s_cmp_eq_u32 s60, 6
    s_cselect_b64 exec, 15, 0
    s_waitcnt lgkmcnt(2)
    buffer_store_dwordx4 v[36:39], v34, s[32:35], s82 offen sc1
    s_mov_b64 exec, -1
    v_mov_b32 v87, 0x3f803f80
    v_mov_b32 v86, 0
    s_waitcnt lgkmcnt(0)
    v_lshlrev_b32 v16, 16, v8
    v_and_b32 v17, 0xffff0000, v8
    v_lshlrev_b32 v18, 16, v24
    v_and_b32 v19, 0xffff0000, v24
    v_pk_mul_f32 v[16:17], v[16:17], v[18:19]
    v_cvt_pk_bf16_f32 v16, v16, v17
    v_dot2_f32_bf16 v86, v16, v87, v86
    v_lshlrev_b32 v20, 16, v9
    v_and_b32 v21, 0xffff0000, v9
    v_lshlrev_b32 v22, 16, v25
    v_and_b32 v23, 0xffff0000, v25
    v_pk_mul_f32 v[20:21], v[20:21], v[22:23]
    v_cvt_pk_bf16_f32 v20, v20, v21
    v_dot2_f32_bf16 v86, v20, v87, v86
    v_lshlrev_b32 v16, 16, v10
    v_and_b32 v17, 0xffff0000, v10
    v_lshlrev_b32 v18, 16, v26
    v_and_b32 v19, 0xffff0000, v26
    v_pk_mul_f32 v[16:17], v[16:17], v[18:19]
    v_cvt_pk_bf16_f32 v16, v16, v17
    v_dot2_f32_bf16 v86, v16, v87, v86
    v_lshlrev_b32 v20, 16, v11
    v_and_b32 v21, 0xffff0000, v11
    v_lshlrev_b32 v22, 16, v27
    v_and_b32 v23, 0xffff0000, v27
    v_pk_mul_f32 v[20:21], v[20:21], v[22:23]
    v_cvt_pk_bf16_f32 v20, v20, v21
    v_dot2_f32_bf16 v86, v20, v87, v86
    v_lshlrev_b32 v16, 16, v12
    v_and_b32 v17, 0xffff0000, v12
    v_lshlrev_b32 v18, 16, v28
    v_and_b32 v19, 0xffff0000, v28
    v_pk_mul_f32 v[16:17], v[16:17], v[18:19]
    v_cvt_pk_bf16_f32 v16, v16, v17
    v_dot2_f32_bf16 v86, v16, v87, v86
    v_lshlrev_b32 v20, 16, v13
    v_and_b32 v21, 0xffff0000, v13
    v_lshlrev_b32 v22, 16, v29
    v_and_b32 v23, 0xffff0000, v29
    v_pk_mul_f32 v[20:21], v[20:21], v[22:23]
    v_cvt_pk_bf16_f32 v20, v20, v21
    v_dot2_f32_bf16 v86, v20, v87, v86
    v_lshlrev_b32 v16, 16, v14
    v_and_b32 v17, 0xffff0000, v14
    v_lshlrev_b32 v18, 16, v30
    v_and_b32 v19, 0xffff0000, v30
    v_pk_mul_f32 v[16:17], v[16:17], v[18:19]
    v_cvt_pk_bf16_f32 v16, v16, v17
    v_dot2_f32_bf16 v86, v16, v87, v86
    v_lshlrev_b32 v20, 16, v15
    v_and_b32 v21, 0xffff0000, v15
    v_lshlrev_b32 v22, 16, v31
    v_and_b32 v23, 0xffff0000, v31
    v_pk_mul_f32 v[20:21], v[20:21], v[22:23]
    v_cvt_pk_bf16_f32 v20, v20, v21
    v_dot2_f32_bf16 v86, v20, v87, v86
    s_nop 2
    v_add_f32_dpp v86, v86, v86 quad_perm:[1,0,3,2] row_mask:0xf bank_mask:0xf
    s_nop 1
    v_add_f32_dpp v86, v86, v86 quad_perm:[2,3,0,1] row_mask:0xf bank_mask:0xf
    s_nop 1
    v_add_f32_dpp v86, v86, v86 row_half_mirror row_mask:0xf bank_mask:0xf
    s_nop 1
    v_add_f32_dpp v86, v86, v86 row_mirror row_mask:0xf bank_mask:0xf
    s_nop 0
    v_readlane_b32 s64, v86, 16
    v_readlane_b32 s65, v86, 32
    v_readlane_b32 s71, v86, 48
    v_add_f32 v86, s64, v86
    v_mov_b32 v80, s65
    v_add_f32 v80, s71, v80
    v_add_f32 v86, v86, v80
    v_cvt_pk_bf16_f32 v86, v86, v86
    v_and_b32 v86, 0xffff0000, v86
    v_mul_f32 v86, 0xbfb8aa3b, v86
    v_exp_f32 v86, v86
    s_nop 0
    v_add_f32 v86, 1.0, v86
    v_rcp_f32 v86, v86
    s_nop 0
    v_cvt_pk_bf16_f32 v86, v86, v86
    v_and_b32 v86, 0xffff0000, v86
    s_lshl_b32 s64, s68, 2
    v_mov_b32 v80, s64
    s_mov_b64 exec, 1
    ds_write_b32 v80, v86 offset:49152
    s_mov_b64 exec, -1
    v_readfirstlane_b32 s3, v5
    s_nop 3
    s_or_b32 s64, s3, s60
    s_cmp_eq_u32 s64, 0
    s_cbranch_scc1 L_nonce_slow
L_nonce_ret:
    v_mov_b32 v64, s3
    v_mov_b32 v65, s3
    v_mov_b32 v66, s3
    v_mov_b32 v67, s3
    v_lshlrev_b32 v68, 4, v1
    s_lshl_b32 s71, s2, 6
    s_add_u32 s71, s71, 0x430000
    s_cmp_eq_u32 s60, 0
    s_cselect_b64 s[84:85], 15, 0
    s_mov_b64 exec, s[84:85]
    ds_write_b32 v4, v64 offset:49184
    s_mov_b64 exec, -1
    s_waitcnt vmcnt(0) lgkmcnt(0)
    s_barrier
    s_mov_b64 exec, s[84:85]
    buffer_store_dwordx4 v[64:67], v68, s[32:35], s71 offen sc1
    s_mov_b64 exec, -1
    buffer_load_short_d16_hi v100, v7, s[44:47], s8 offen
    buffer_load_short_d16_hi v108, v7, s[48:51], s8 offen
    buffer_load_short_d16_hi v101, v7, s[44:47], s9 offen
    buffer_load_short_d16_hi v109, v7, s[48:51], s9 offen
    buffer_load_short_d16_hi v102, v7, s[44:47], s10 offen
    buffer_load_short_d16_hi v110, v7, s[48:51], s10 offen
    buffer_load_short_d16_hi v103, v7, s[44:47], s11 offen
    buffer_load_short_d16_hi v111, v7, s[48:51], s11 offen
    buffer_load_short_d16_hi v112, v7, s[52:55], s4 offen
    buffer_load_short_d16_hi v120, v7, s[56:59], s4 offen
    buffer_load_short_d16_hi v113, v7, s[52:55], s5 offen
    buffer_load_short_d16_hi v121, v7, s[56:59], s5 offen
    buffer_load_short_d16_hi v114, v7, s[52:55], s6 offen
    buffer_load_short_d16_hi v122, v7, s[56:59], s6 offen
    buffer_load_short_d16_hi v115, v7, s[52:55], s7 offen
    buffer_load_short_d16_hi v123, v7, s[56:59], s7 offen
    buffer_load_short_d16_hi v116, v7, s[52:55], s8 offen
    buffer_load_short_d16_hi v124, v7, s[56:59], s8 offen
    buffer_load_short_d16_hi v117, v7, s[52:55], s9 offen
    buffer_load_short_d16_hi v125, v7, s[56:59], s9 offen
    v_lshlrev_b32 v88, 12, v3
    v_lshl_add_u32 v90, v2, 4, v88
    v_lshlrev_b32 v88, 17, v3
    v_lshl_add_u32 v88, v2, 2, v88
    s_lshl_b32 s88, s2, 14
    s_lshl_b32 s64, s60, 11
    s_add_u32 s88, s88, s64
    v_cvt_f32_u32 v8, v2
    v_lshlrev_b32 v9, 2, v3
    v_cvt_f32_u32 v9, v9
    v_mul_f32 v8, 0x3d800000, v8
    v_mul_f32 v14, v9, v8
    v_cos_f32 v11, v14
    v_sin_f32 v12, v14
    s_nop 0
    v_cvt_pk_bf16_f32 v16, v11, v12
    v_cvt_pk_bf16_f32 v20, -v12, v11
    v_fmamk_f32 v10, v8, 0x3f800000, v14
    v_cos_f32 v11, v10
    v_sin_f32 v12, v10
    s_nop 0
    v_cvt_pk_bf16_f32 v17, v11, v12
    v_cvt_pk_bf16_f32 v21, -v12, v11
    v_fmamk_f32 v10, v8, 0x40000000, v14
    v_cos_f32 v11, v10
    v_sin_f32 v12, v10
    s_nop 0
    v_cvt_pk_bf16_f32 v18, v11, v12
    v_cvt_pk_bf16_f32 v22, -v12, v11
    v_fmamk_f32 v10, v8, 0x40400000, v14
    v_cos_f32 v11, v10
    v_sin_f32 v12, v10
    s_nop 0
    v_cvt_pk_bf16_f32 v19, v11, v12
    v_cvt_pk_bf16_f32 v23, -v12, v11
    s_lshl_b32 s64, s60, 1
    v_cvt_f32_u32 v13, s64
    v_fmamk_f32 v13, v13, 0x3b800000, v8
    v_mul_f32 v14, v9, v13
    v_cos_f32 v11, v14
    v_sin_f32 v12, v14
    s_nop 0
    v_cvt_pk_bf16_f32 v40, v11, v12
    v_cvt_pk_bf16_f32 v44, -v12, v11
    v_fmamk_f32 v10, v13, 0x3f800000, v14
    v_cos_f32 v11, v10
    v_sin_f32 v12, v10
    s_nop 0
    v_cvt_pk_bf16_f32 v41, v11, v12
    v_cvt_pk_bf16_f32 v45, -v12, v11
    v_fmamk_f32 v10, v13, 0x40000000, v14
    v_cos_f32 v11, v10
    v_sin_f32 v12, v10
    s_nop 0
    v_cvt_pk_bf16_f32 v42, v11, v12
    v_cvt_pk_bf16_f32 v46, -v12, v11
    v_fmamk_f32 v10, v13, 0x40400000, v14
    v_cos_f32 v11, v10
    v_sin_f32 v12, v10
    s_nop 0
    v_cvt_pk_bf16_f32 v43, v11, v12
    v_cvt_pk_bf16_f32 v47, -v12, v11
    v_add_f32 v13, 0x3b800000, v13
    v_mul_f32 v14, v9, v13
    v_cos_f32 v11, v14
    v_sin_f32 v12, v14
    s_nop 0
    v_cvt_pk_bf16_f32 v48, v11, v12
    v_cvt_pk_bf16_f32 v52, -v12, v11
    v_fmamk_f32 v10, v13, 0x3f800000, v14
    v_cos_f32 v11, v10
    v_sin_f32 v12, v10
    s_nop 0
    v_cvt_pk_bf16_f32 v49, v11, v12
    v_cvt_pk_bf16_f32 v53, -v12, v11
    v_fmamk_f32 v10, v13, 0x40000000, v14
    v_cos_f32 v11, v10
    v_sin_f32 v12, v10
    s_nop 0
    v_cvt_pk_bf16_f32 v50, v11, v12
    v_cvt_pk_bf16_f32 v54, -v12, v11
    v_fmamk_f32 v10, v13, 0x40400000, v14
    v_cos_f32 v11, v10
    v_sin_f32 v12, v10
    s_nop 0
    v_cvt_pk_bf16_f32 v51, v11, v12
    v_cvt_pk_bf16_f32 v55, -v12, v11
    s_lshl_b32 s64, s62, 8
    s_lshl_b32 s65, s61, 3
    s_add_u32 s64, s64, s65
    v_add_u32 v90, s64, v90
    s_lshl_b32 s64, s60, 11
    v_lshl_add_u32 v91, v1, 4, s64
    v_lshlrev_b32 v92, 4, v3
    v_lshl_add_u32 v89, v2, 15, v92
    v_lshl_add_u32 v92, v2, 6, v92
    s_lshl_b32 s72, s66, 19
    s_lshl_b32 s64, s67, 6
    s_add_u32 s72, s72, s64
    s_lshl_b32 s64, s60, 12
    s_add_u32 s72, s72, s64
    s_add_u32 s73, s72, 32768
    s_add_u32 s74, s72, 65536
    s_add_u32 s75, s72, 98304
    s_lshl_b32 s64, s67, 3
    s_or_b32 s64, s64, s60
    s_cmp_eq_u32 s64, 249
    s_cselect_b32 s83, 2, 0
    s_cbranch_scc1 L_spB
L_spD_ret:
    s_lshr_b32 s83, s83, 1
    s_and_b32 s87, s2, 15
    s_lshl_b32 s87, s87, 12
    s_add_u32 s89, s87, 0x430000
    s_cmp_lg_u32 s60, 0
    s_cbranch_scc1 L_p2go
    s_mov_b32 s64, 0
    v_lshlrev_b32 v13, 6, v1
    s_mov_b32 s92, 0x430000
    s_mov_b32 s93, 0x431000
    s_mov_b32 s94, 0x432000
    s_mov_b32 s95, 0x433000
L_poll1:
    buffer_load_dword v8, v13, s[32:35], s92 offen sc1
    buffer_load_dword v9, v13, s[32:35], s93 offen sc1
    buffer_load_dword v10, v13, s[32:35], s94 offen sc1
    buffer_load_dword v11, v13, s[32:35], s95 offen sc1
    s_add_u32 s64, s64, 1
    s_waitcnt vmcnt(0)
    v_xor_b32 v8, s3, v8
    v_xor_b32 v9, s3, v9
    v_xor_b32 v10, s3, v10
    v_xor_b32 v11, s3, v11
    v_or3_b32 v8, v8, v9, v10
    v_or_b32 v8, v8, v11
    v_cmp_ne_u32 vcc, 0, v8
    s_nop 3
    s_cmp_eq_u64 vcc, 0
    s_cbranch_scc1 L_poll1_ok
    s_mov_b64 exec, vcc
    s_sleep 4
    s_cmp_lt_u32 s64, 0x40000
    s_cbranch_scc1 L_poll1
L_poll1_ok:
    s_mov_b64 exec, -1
L_p2go:
    s_barrier
    buffer_load_dword v24, v88, s[36:39], s72 offen offset:0 sc1
    buffer_load_dword v25, v88, s[36:39], s73 offen offset:0 sc1
    buffer_load_dword v26, v88, s[36:39], s74 offen offset:0 sc1
    buffer_load_dword v27, v88, s[36:39], s75 offen offset:0 sc1
    buffer_load_dword v28, v88, s[36:39], s72 offen offset:2048 sc1
    buffer_load_dword v29, v88, s[36:39], s73 offen offset:2048 sc1
    buffer_load_dword v30, v88, s[36:39], s74 offen offset:2048 sc1
    buffer_load_dword v31, v88, s[36:39], s75 offen offset:2048 sc1
    s_barrier
    buffer_load_short_d16_hi v118, v7, s[52:55], s10 offen
    buffer_load_short_d16_hi v126, v7, s[56:59], s10 offen
    buffer_load_short_d16_hi v119, v7, s[52:55], s11 offen
    buffer_load_short_d16_hi v127, v7, s[56:59], s11 offen
    s_waitcnt vmcnt(8)
    v_mfma_f32_16x16x32_bf16 v[56:59], v[16:19], v[24:27], 0
    v_mfma_f32_16x16x32_bf16 v[60:63], v[20:23], v[24:27], 0
    s_waitcnt vmcnt(4)
    v_mfma_f32_16x16x32_bf16 v[64:67], v[16:19], v[28:31], 0
    v_mfma_f32_16x16x32_bf16 v[68:71], v[20:23], v[28:31], 0
    s_nop 4
    v_cvt_pk_bf16_f32 v32, v56, v60
    s_nop 1
    v_cvt_pk_bf16_f32 v33, v64, v68
    ds_write_b64 v90, v[32:33] offset:0
    v_cvt_pk_bf16_f32 v34, v57, v61
    v_cvt_pk_bf16_f32 v35, v65, v69
    ds_write_b64 v90, v[34:35] offset:1024
    v_cvt_pk_bf16_f32 v36, v58, v62
    v_cvt_pk_bf16_f32 v37, v66, v70
    ds_write_b64 v90, v[36:37] offset:2048
    v_cvt_pk_bf16_f32 v38, v59, v63
    v_cvt_pk_bf16_f32 v39, v67, v71
    ds_write_b64 v90, v[38:39] offset:3072
    s_waitcnt lgkmcnt(0)
    s_barrier
    ds_read_b128 v[24:27], v91 offset:0
    ds_read_b128 v[28:31], v91 offset:1024
    s_waitcnt lgkmcnt(1)
    v_mfma_f32_16x16x32_bf16 v[72:75], v[40:43], v[24:27], 0
    v_mfma_f32_16x16x32_bf16 v[76:79], v[44:47], v[24:27], 0
    s_waitcnt lgkmcnt(0)
    v_mfma_f32_16x16x32_bf16 v[80:83], v[48:51], v[28:31], 0
    v_mfma_f32_16x16x32_bf16 v[84:87], v[52:55], v[28:31], 0
    s_nop 4
    v_pk_mul_f32 v[8:9], v[76:77], v[104:105]
    v_pk_mul_f32 v[10:11], v[76:77], v[96:97]
    v_pk_fma_f32 v[8:9], v[72:73], v[96:97], v[8:9] neg_lo:[0,0,1] neg_hi:[0,0,1]
    v_pk_fma_f32 v[10:11], v[72:73], v[104:105], v[10:11] neg_lo:[1,0,1] neg_hi:[1,0,1]
    v_cvt_pk_bf16_f32 v24, v8, v10
    v_cvt_pk_bf16_f32 v25, v9, v11
    v_pk_mul_f32 v[12:13], v[78:79], v[106:107]
    v_pk_mul_f32 v[14:15], v[78:79], v[98:99]
    v_pk_fma_f32 v[12:13], v[74:75], v[98:99], v[12:13] neg_lo:[0,0,1] neg_hi:[0,0,1]
    v_pk_fma_f32 v[14:15], v[74:75], v[106:107], v[14:15] neg_lo:[1,0,1] neg_hi:[1,0,1]
    v_cvt_pk_bf16_f32 v26, v12, v14
    v_cvt_pk_bf16_f32 v27, v13, v15
    s_nop 1
    v_mfma_f32_16x16x32_bf16 v[56:59], v[16:19], v[24:27], 0
    v_mfma_f32_16x16x32_bf16 v[60:63], v[20:23], v[24:27], 0
    v_pk_mul_f32 v[8:9], v[84:85], v[108:109]
    v_pk_mul_f32 v[10:11], v[84:85], v[100:101]
    v_pk_fma_f32 v[8:9], v[80:81], v[100:101], v[8:9] neg_lo:[0,0,1] neg_hi:[0,0,1]
    v_pk_fma_f32 v[10:11], v[80:81], v[108:109], v[10:11] neg_lo:[1,0,1] neg_hi:[1,0,1]
    v_cvt_pk_bf16_f32 v28, v8, v10
    v_cvt_pk_bf16_f32 v29, v9, v11
    v_pk_mul_f32 v[12:13], v[86:87], v[110:111]
    v_pk_mul_f32 v[14:15], v[86:87], v[102:103]
    v_pk_fma_f32 v[12:13], v[82:83], v[102:103], v[12:13] neg_lo:[0,0,1] neg_hi:[0,0,1]
    v_pk_fma_f32 v[14:15], v[82:83], v[110:111], v[14:15] neg_lo:[1,0,1] neg_hi:[1,0,1]
    v_cvt_pk_bf16_f32 v30, v12, v14
    v_cvt_pk_bf16_f32 v31, v13, v15
    s_nop 1
    v_mfma_f32_16x16x32_bf16 v[64:67], v[16:19], v[28:31], 0
    v_mfma_f32_16x16x32_bf16 v[68:71], v[20:23], v[28:31], 0
    v_pk_mul_f32 v[8:9], v[76:77], v[120:121]
    v_pk_mul_f32 v[10:11], v[76:77], v[112:113]
    v_pk_fma_f32 v[8:9], v[72:73], v[112:113], v[8:9] neg_lo:[0,0,1] neg_hi:[0,0,1]
    v_pk_fma_f32 v[10:11], v[72:73], v[120:121], v[10:11] neg_lo:[1,0,1] neg_hi:[1,0,1]
    v_cvt_pk_bf16_f32 v32, v8, v10
    v_cvt_pk_bf16_f32 v33, v9, v11
    v_pk_mul_f32 v[12:13], v[78:79], v[122:123]
    v_pk_mul_f32 v[14:15], v[78:79], v[114:115]
    v_pk_fma_f32 v[12:13], v[74:75], v[114:115], v[12:13] neg_lo:[0,0,1] neg_hi:[0,0,1]
    v_pk_fma_f32 v[14:15], v[74:75], v[122:123], v[14:15] neg_lo:[1,0,1] neg_hi:[1,0,1]
    v_cvt_pk_bf16_f32 v34, v12, v14
    v_cvt_pk_bf16_f32 v35, v13, v15
    s_nop 1
    v_mfma_f32_16x16x32_bf16 v[96:99], v[16:19], v[32:35], 0
    v_mfma_f32_16x16x32_bf16 v[100:103], v[20:23], v[32:35], 0
    v_cvt_pk_bf16_f32 v24, v56, v60
    v_cvt_pk_bf16_f32 v25, v64, v68
    ds_write_b64 v90, v[24:25] offset:16384
    v_cvt_pk_bf16_f32 v26, v57, v61
    v_cvt_pk_bf16_f32 v27, v65, v69
    ds_write_b64 v90, v[26:27] offset:17408
    v_cvt_pk_bf16_f32 v28, v58, v62
    v_cvt_pk_bf16_f32 v29, v66, v70
    ds_write_b64 v90, v[28:29] offset:18432
    v_cvt_pk_bf16_f32 v30, v59, v63
    v_cvt_pk_bf16_f32 v31, v67, v71
    ds_write_b64 v90, v[30:31] offset:19456
    s_waitcnt lgkmcnt(0)
    s_barrier
    ds_read_b128 v[24:27], v91 offset:16384
    ds_read_b128 v[28:31], v91 offset:17408
    s_waitcnt vmcnt(0)
    v_pk_mul_f32 v[8:9], v[84:85], v[124:125]
    v_pk_mul_f32 v[10:11], v[84:85], v[116:117]
    v_pk_fma_f32 v[8:9], v[80:81], v[116:117], v[8:9] neg_lo:[0,0,1] neg_hi:[0,0,1]
    v_pk_fma_f32 v[10:11], v[80:81], v[124:125], v[10:11] neg_lo:[1,0,1] neg_hi:[1,0,1]
    v_cvt_pk_bf16_f32 v36, v8, v10
    v_cvt_pk_bf16_f32 v37, v9, v11
    v_pk_mul_f32 v[12:13], v[86:87], v[126:127]
    v_pk_mul_f32 v[14:15], v[86:87], v[118:119]
    v_pk_fma_f32 v[12:13], v[82:83], v[118:119], v[12:13] neg_lo:[0,0,1] neg_hi:[0,0,1]
    v_pk_fma_f32 v[14:15], v[82:83], v[126:127], v[14:15] neg_lo:[1,0,1] neg_hi:[1,0,1]
    v_cvt_pk_bf16_f32 v38, v12, v14
    v_cvt_pk_bf16_f32 v39, v13, v15
    s_nop 1
    v_mfma_f32_16x16x32_bf16 v[104:107], v[16:19], v[36:39], 0
    v_mfma_f32_16x16x32_bf16 v[108:111], v[20:23], v[36:39], 0
    s_waitcnt lgkmcnt(0)
    v_mfma_f32_16x16x32_bf16 v[56:59], v[24:27], v[40:43], 0
    v_mfma_f32_16x16x32_bf16 v[60:63], v[24:27], v[44:47], 0
    v_mfma_f32_16x16x32_bf16 v[64:67], v[28:31], v[48:51], 0
    v_mfma_f32_16x16x32_bf16 v[68:71], v[28:31], v[52:55], 0
    v_cvt_pk_bf16_f32 v112, v96, v100
    s_nop 1
    v_cvt_pk_bf16_f32 v113, v104, v108
    ds_write_b64 v90, v[112:113] offset:32768
    v_cvt_pk_bf16_f32 v114, v97, v101
    v_cvt_pk_bf16_f32 v115, v105, v109
    ds_write_b64 v90, v[114:115] offset:33792
    v_cvt_pk_bf16_f32 v116, v98, v102
    v_cvt_pk_bf16_f32 v117, v106, v110
    ds_write_b64 v90, v[116:117] offset:34816
    v_cvt_pk_bf16_f32 v118, v99, v103
    v_cvt_pk_bf16_f32 v119, v107, v111
    ds_write_b64 v90, v[118:119] offset:35840
    v_cvt_pk_bf16_f32 v120, v56, v60
    v_cvt_pk_bf16_f32 v121, v57, v61
    v_cvt_pk_bf16_f32 v122, v58, v62
    v_cvt_pk_bf16_f32 v123, v59, v63
    buffer_store_dwordx4 v[120:123], v92, s[32:35], s88 offen offset:0 sc1
    v_cvt_pk_bf16_f32 v124, v64, v68
    v_cvt_pk_bf16_f32 v125, v65, v69
    v_cvt_pk_bf16_f32 v126, v66, v70
    v_cvt_pk_bf16_f32 v127, v67, v71
    buffer_store_dwordx4 v[124:127], v92, s[32:35], s88 offen offset:1024 sc1
    s_waitcnt lgkmcnt(0)
    s_barrier
    ds_read_b128 v[32:35], v91 offset:32768
    ds_read_b128 v[36:39], v91 offset:33792
    s_cmp_eq_u32 s83, 1
    s_cbranch_scc1 L_spA
L_spA_ret:
    s_waitcnt lgkmcnt(0)
    v_mfma_f32_16x16x32_bf16 v[72:75], v[32:35], v[40:43], 0
    v_mfma_f32_16x16x32_bf16 v[76:79], v[32:35], v[44:47], 0
    v_mfma_f32_16x16x32_bf16 v[80:83], v[36:39], v[48:51], 0
    v_mfma_f32_16x16x32_bf16 v[84:87], v[36:39], v[52:55], 0
    s_nop 5
    v_cvt_pk_bf16_f32 v112, v72, v76
    v_cvt_pk_bf16_f32 v113, v73, v77
    v_cvt_pk_bf16_f32 v114, v74, v78
    v_cvt_pk_bf16_f32 v115, v75, v79
    buffer_store_dwordx4 v[112:115], v89, s[36:39], s72 offen offset:0 sc1
    v_cvt_pk_bf16_f32 v116, v80, v84
    v_cvt_pk_bf16_f32 v117, v81, v85
    v_cvt_pk_bf16_f32 v118, v82, v86
    v_cvt_pk_bf16_f32 v119, v83, v87
    buffer_store_dwordx4 v[116:119], v89, s[36:39], s72 offen offset:2048 sc1
    s_cmp_eq_u32 s83, 1
    s_nop 0
    s_cbranch_scc1 L_spB
L_spB_ret:
    v_lshl_add_u32 v80, s61, 4, v2
    v_cvt_f32_u32 v81, v80
    v_lshlrev_b32 v82, 3, v3
    v_cvt_f32_u32 v82, v82
    v_mul_f32 v81, 0x3d000000, v81
    v_mul_f32 v82, v82, v81
    v_cos_f32 v84, v82
    v_sin_f32 v85, v82
    v_mul_f32 v32, 0x3d000000, v82
    v_cvt_pk_bf16_f32 v8, v84, v85
    v_cvt_pk_bf16_f32 v16, -v85, v84
    v_fmamk_f32 v83, v81, 0x3f800000, v82
    v_cos_f32 v86, v83
    v_sin_f32 v87, v83
    v_mul_f32 v33, 0x3d000000, v83
    v_cvt_pk_bf16_f32 v12, v86, v87
    v_cvt_pk_bf16_f32 v20, -v87, v86
    v_fmamk_f32 v83, v81, 0x40000000, v82
    v_cos_f32 v84, v83
    v_sin_f32 v85, v83
    v_mul_f32 v34, 0x3d000000, v83
    v_cvt_pk_bf16_f32 v9, v84, v85
    v_cvt_pk_bf16_f32 v17, -v85, v84
    v_fmamk_f32 v83, v81, 0x40400000, v82
    v_cos_f32 v86, v83
    v_sin_f32 v87, v83
    v_mul_f32 v35, 0x3d000000, v83
    v_cvt_pk_bf16_f32 v13, v86, v87
    v_cvt_pk_bf16_f32 v21, -v87, v86
    v_fmamk_f32 v83, v81, 0x40800000, v82
    v_cos_f32 v84, v83
    v_sin_f32 v85, v83
    v_mul_f32 v36, 0x3d000000, v83
    v_cvt_pk_bf16_f32 v10, v84, v85
    v_cvt_pk_bf16_f32 v18, -v85, v84
    v_fmamk_f32 v83, v81, 0x40a00000, v82
    v_cos_f32 v86, v83
    v_sin_f32 v87, v83
    v_mul_f32 v37, 0x3d000000, v83
    v_cvt_pk_bf16_f32 v14, v86, v87
    v_cvt_pk_bf16_f32 v22, -v87, v86
    v_fmamk_f32 v83, v81, 0x40c00000, v82
    v_cos_f32 v84, v83
    v_sin_f32 v85, v83
    v_mul_f32 v38, 0x3d000000, v83
    v_cvt_pk_bf16_f32 v11, v84, v85
    v_cvt_pk_bf16_f32 v19, -v85, v84
    v_fmamk_f32 v83, v81, 0x40e00000, v82
    v_cos_f32 v86, v83
    v_sin_f32 v87, v83
    v_mul_f32 v39, 0x3d000000, v83
    v_cvt_pk_bf16_f32 v15, v86, v87
    v_cvt_pk_bf16_f32 v23, -v87, v86
    v_cos_f32 v24, v32
    v_sin_f32 v32, v32
    v_cos_f32 v25, v33
    v_sin_f32 v33, v33
    v_cos_f32 v26, v34
    v_sin_f32 v34, v34
    v_cos_f32 v27, v35
    v_sin_f32 v35, v35
    v_cos_f32 v28, v36
    v_sin_f32 v36, v36
    v_cos_f32 v29, v37
    v_sin_f32 v37, v37
    v_cos_f32 v30, v38
    v_sin_f32 v38, v38
    v_cos_f32 v31, v39
    v_sin_f32 v39, v39
    v_mov_b32 v80, s3
    v_lshlrev_b32 v84, 10, v1
    s_lshl_b32 s71, s2, 2
    s_add_u32 s71, s71, 0x450000
    s_mov_b32 s84, 0xffffffff
    s_mov_b32 s85, 0xffffffff
    s_cmp_eq_u32 s60, 0
    s_cselect_b64 s[84:85], s[84:85], 0
    v_lshlrev_b32 v56, 2, v1
    s_and_b32 s64, s60, 3
    s_lshl_b32 s64, s64, 8
    v_add_u32 v56, s64, v56
    ds_write_b32 v56, v4 offset:49280
    s_waitcnt vmcnt(0) lgkmcnt(0)
    s_barrier
    s_mov_b64 exec, s[84:85]
    buffer_store_dword v80, v84, s[32:35], s71 offen sc1
    s_mov_b64 exec, -1
    v_lshlrev_b32 v61, 3, v1
    s_and_b32 s79, s2, 63
    s_lshl_b32 s79, s79, 10
    s_add_u32 s79, s79, 0x450000
    v_mov_b32 v56, 0
    v_mov_b32 v57, 0
    v_mov_b32 v58, 0
    v_mov_b32 v59, 0
    s_cmp_eq_u32 s60, 0
    s_cselect_b64 exec, -1, 0
    buffer_atomic_or_x2 v[56:57], v61, s[32:35], s79 offen sc0 sc1
    buffer_atomic_or_x2 v[58:59], v61, s[32:35], s79 offen offset:512 sc0 sc1
    s_mov_b64 exec, -1
    v_and_b32 v80, 12, v2
    ds_read_b32 v94, v80 offset:49152
    ds_read_b32 v95, v80 offset:49168
    ds_read_b32 v5, v4 offset:49184
    v_lshlrev_b32 v88, 13, v3
    v_lshl_add_u32 v88, v2, 3, v88
    s_lshr_b32 s66, s60, 2
    s_and_b32 s67, s62, 1
    s_lshl_b32 s64, s63, 15
    s_lshl_b32 s72, s66, 11
    s_and_b32 s65, s60, 3
    s_lshl_b32 s65, s65, 7
    s_add_u32 s72, s72, s65
    s_add_u32 s72, s72, s64
    s_add_u32 s72, s72, 0x480000
    s_add_u32 s73, s72, 4096
    v_lshlrev_b32 v88, 15, v3
    v_lshl_add_u32 v88, v2, 2, v88
    s_lshl_b32 s4, s66, 21
    s_and_b32 s64, s60, 3
    s_lshl_b32 s65, s64, 17
    s_add_u32 s4, s4, s65
    s_and_b32 s65, s63, 15
    s_lshl_b32 s65, s65, 10
    s_add_u32 s4, s4, s65
    s_lshr_b32 s65, s63, 4
    s_lshl_b32 s65, s65, 6
    s_add_u32 s4, s4, s65
    s_add_u32 s5, s4, 16384
    s_add_u32 s6, s4, 524288
    s_add_u32 s7, s4, 540672
    s_add_u32 s8, s4, 1048576
    s_add_u32 s9, s4, 1064960
    s_add_u32 s10, s4, 1572864
    s_add_u32 s11, s4, 1589248
    v_lshlrev_b32 v105, 20, v3
    v_lshl_add_u32 v105, v2, 2, v105
    s_lshl_b32 s72, s66, 10
    s_lshl_b32 s64, s64, 6
    s_add_u32 s72, s72, s64
    s_lshl_b32 s64, s63, 11
    s_add_u32 s72, s72, s64
    s_add_u32 s73, s72, 524288
    s_lshr_b32 s74, s63, 3
    s_lshl_b32 s74, s74, 9
    s_and_b32 s75, s63, 7
    s_lshl_b32 s75, s75, 3
    s_add_u32 s74, s74, s75
    s_add_u32 s74, s74, 0x420000
    v_lshlrev_b32 v106, 7, v3
    v_lshrrev_b32 v80, 2, v2
    v_lshl_add_u32 v80, v80, 8, s63
    v_cvt_f32_u32 v80, v80
    v_and_b32 v93, 2, v2
    v_cvt_f32_u32 v93, v93
    v_add_f32 v93, -1.0, v93
    v_mul_f32 v80, 0xba000000, v80
    v_mul_f32 v80, v80, v93
    v_and_b32 v81, 1, v2
    v_cvt_f32_u32 v81, v81
    v_mul_f32 v81, 0x3e800000, v81
    v_lshlrev_b32 v82, 1, v3
    v_cvt_f32_u32 v82, v82
    v_fma_f32 v83, v82, v80, v81
    v_add_f32 v84, v83, v80
    v_cos_f32 v64, v83
    v_sin_f32 v66, v83
    v_mul_f32 v64, 0x34b504f3, v64
    v_mul_f32 v66, 0x34b504f3, v66
    v_mul_f32 v68, v93, v64
    v_mul_f32 v70, v93, v66
    v_cos_f32 v65, v84
    v_sin_f32 v67, v84
    v_mul_f32 v65, 0x34b504f3, v65
    v_mul_f32 v67, 0x34b504f3, v67
    v_mul_f32 v69, v93, v65
    v_mul_f32 v71, v93, v67
    v_lshlrev_b32 v104, 12, v3
    v_lshl_add_u32 v81, s61, 4, v2
    v_bfe_u32 v82, v81, 3, 2
    v_lshlrev_b32 v90, 6, v82
    v_and_b32 v82, 3, v81
    v_lshl_add_u32 v90, v82, 4, v90
    v_bfe_u32 v82, v81, 2, 1
    v_mul_u32_u24 v82, 2112, v82
    v_xor_b32 v90, v90, v82
    s_lshl_b32 s64, s67, 10
    s_lshl_b32 s65, s66, 8
    s_add_u32 s68, s64, s65
    v_add3_u32 v90, v90, v104, s68
    v_sub_u32 v83, 32, v81
    v_bfe_u32 v82, v83, 3, 2
    v_lshlrev_b32 v91, 6, v82
    v_and_b32 v82, 3, v83
    v_lshl_add_u32 v91, v82, 4, v91
    v_bfe_u32 v82, v83, 2, 1
    v_mul_u32_u24 v82, 2112, v82
    v_xor_b32 v91, v91, v82
    s_sub_u32 s69, 1792, s68
    v_add3_u32 v91, v91, v104, s69
    v_cmp_eq_u32 vcc, 0, v81
    s_sub_u32 s69, 768, s65
    v_add_u32 v92, s69, v104
    v_add_u32 v82, 1024, v92
    s_cmp_eq_u32 s67, 0
    s_cselect_b64 s[80:81], vcc, 0
    v_cndmask_b32 v91, v91, v82, vcc
    v_mov_b32 v82, 16384
    v_cndmask_b32 v91, v91, v82, s[80:81]
    s_cmp_eq_u32 s60, 0
    s_cselect_b64 s[82:83], s[80:81], 0
    s_lshl_b32 s64, s62, 12
    v_lshl_add_u32 v98, v1, 4, s64
    v_xor_b32 v99, 64, v98
    v_lshlrev_b32 v89, 6, v2
    v_lshl_add_u32 v89, v3, 3, v89
    s_lshl_b32 s64, s62, 8
    s_add_u32 s64, s64, s63
    s_lshl_b32 s64, s64, 11
    s_lshl_b32 s65, s61, 5
    s_add_u32 s76, s64, s65
    s_add_u32 s77, s76, 2097152
    v_add_u32 v107, s65, v89
    v_bfe_u32 v80, v2, 1, 3
    v_lshlrev_b32 v80, 4, v80
    v_xor_b32 v107, v107, v80
    s_lshl_b32 s64, s62, 11
    v_add_u32 v107, s64, v107
    v_lshlrev_b32 v109, 4, v1
    v_lshrrev_b32 v80, 3, v1
    v_lshlrev_b32 v80, 4, v80
    v_xor_b32 v108, v109, v80
    s_lshl_b32 s64, s60, 11
    v_add_u32 v108, s64, v108
    s_lshl_b32 s78, s60, 8
    s_add_u32 s78, s78, s63
    s_lshl_b32 s78, s78, 11
    v_cmp_eq_u32 vcc, 0, v2
    s_cmp_eq_u32 s60, 7
    s_nop 2
    s_cselect_b64 s[84:85], vcc, 0
    s_waitcnt lgkmcnt(0)
    v_readfirstlane_b32 s3, v5
    v_sub_f32 v96, 1.0, v94
    v_sub_f32 v97, 1.0, v95
    v_cvt_pk_bf16_f32 v97, v96, v97
    v_lshlrev_b32 v96, 16, v97
    v_and_b32 v97, 0xffff0000, v97
    v_mul_f32 v80, v94, v64
    v_mul_f32 v81, v94, v70
    v_fma_f32 v80, v95, v66, v80
    v_fma_f32 v81, v95, v68, -v81
    v_cvt_pk_bf16_f32 v100, v80, v81
    v_mul_f32 v80, v96, v64
    v_mul_f32 v81, v96, v70
    v_fma_f32 v80, v97, v66, v80
    v_fma_f32 v81, v97, v68, -v81
    v_cvt_pk_bf16_f32 v101, v80, v81
    v_mul_f32 v80, v94, v65
    v_mul_f32 v81, v94, v71
    v_fma_f32 v80, -v95, v67, v80
    v_fma_f32 v81, -v95, v69, -v81
    v_cvt_pk_bf16_f32 v102, v80, v81
    v_mul_f32 v80, v96, v65
    v_mul_f32 v81, v96, v71
    v_fma_f32 v80, -v97, v67, v80
    v_fma_f32 v81, -v97, v69, -v81
    v_cvt_pk_bf16_f32 v103, v80, v81
    s_add_u32 s89, s87, 0x450000
    v_lshlrev_b32 v82, 7, v2
    v_lshl_add_u32 v82, v3, 3, v82
    v_and_b32 v82, 0x1ff, v82
    s_lshl_b32 s92, s66, 9
    s_and_b32 s64, s60, 3
    s_lshl_b32 s64, s64, 5
    s_add_u32 s92, s92, s64
    v_add_u32 v82, s92, v82
    s_mov_b32 s12, 0x000f000f
    s_mov_b32 s13, 0x000f000f
    s_mov_b64 s[14:15], s[12:13]
    s_mov_b32 s94, 0x00010001
    s_mov_b32 s95, 0x00010001
    s_mov_b32 s93, 0
    s_cmp_lg_u32 s60, 0
    s_cbranch_scc1 L_prog0
    s_mov_b32 s64, 0
L_poll2:
    s_add_u32 s64, s64, 1
    s_waitcnt vmcnt(0)
    ds_write_b64 v61, v[56:57] offset:49280
    ds_write_b64 v61, v[58:59] offset:49792
    v_xor_b32 v64, s3, v56
    v_xor_b32 v65, s3, v57
    v_xor_b32 v66, s3, v58
    v_xor_b32 v67, s3, v59
    v_or3_b32 v64, v64, v65, v66
    v_or_b32 v64, v64, v67
    v_cmp_ne_u32 vcc, 0, v64
    s_nop 3
    s_cmp_eq_u64 vcc, 0
    s_cbranch_scc1 L_poll2_ok
    s_mov_b64 exec, vcc
    s_waitcnt lgkmcnt(0)
    v_mov_b32 v56, 0
    v_mov_b32 v57, 0
    v_mov_b32 v58, 0
    v_mov_b32 v59, 0
    buffer_atomic_or_x2 v[56:57], v61, s[32:35], s79 offen sc0 sc1
    buffer_atomic_or_x2 v[58:59], v61, s[32:35], s79 offen offset:512 sc0 sc1
    s_cmp_lt_u32 s64, 0x40000
    s_cbranch_scc1 L_poll2
L_poll2_ok:
    s_mov_b64 exec, -1
L_prog0:
    s_mov_b64 exec, -1
    ds_read_b64 v[80:81], v82 offset:49280
L_prog:
    s_waitcnt lgkmcnt(0)
    s_mov_b64 exec, -1
    v_cmp_eq_u32 s[16:17], s3, v80
    v_cmp_eq_u32 s[70:71], s3, v81
    s_add_u32 s93, s93, 1
    s_nop 1
    s_and_b64 s[16:17], s[16:17], s[12:13]
    s_and_b64 s[70:71], s[70:71], s[14:15]
    s_andn2_b64 s[12:13], s[12:13], s[16:17]
    s_andn2_b64 s[14:15], s[14:15], s[70:71]
    s_or_b64 s[64:65], s[16:17], s[70:71]
    s_cbranch_scc0 L_prog_idle
    s_and_b64 s[64:65], s[16:17], s[94:95]
    s_mul_i32 exec_lo, s64, 0xffff
    s_mul_i32 exec_hi, s65, 0xffff
    buffer_load_dword v40, v88, s[32:35], s4 offen sc1
    buffer_load_dword v41, v105, s[36:39], s72 offen offset:0 sc1
    s_and_b64 s[64:65], s[70:71], s[94:95]
    s_mul_i32 exec_lo, s64, 0xffff
    s_mul_i32 exec_hi, s65, 0xffff
    buffer_load_dword v42, v88, s[32:35], s5 offen sc1
    buffer_load_dword v43, v105, s[36:39], s73 offen offset:0 sc1
    s_lshr_b64 s[64:65], s[16:17], 1
    s_and_b64 s[64:65], s[64:65], s[94:95]
    s_mul_i32 exec_lo, s64, 0xffff
    s_mul_i32 exec_hi, s65, 0xffff
    buffer_load_dword v44, v88, s[32:35], s6 offen sc1
    buffer_load_dword v45, v105, s[36:39], s72 offen offset:256 sc1
    s_lshr_b64 s[64:65], s[70:71], 1
    s_and_b64 s[64:65], s[64:65], s[94:95]
    s_mul_i32 exec_lo, s64, 0xffff
    s_mul_i32 exec_hi, s65, 0xffff
    buffer_load_dword v46, v88, s[32:35], s7 offen sc1
    buffer_load_dword v47, v105, s[36:39], s73 offen offset:256 sc1
    s_lshr_b64 s[64:65], s[16:17], 2
    s_and_b64 s[64:65], s[64:65], s[94:95]
    s_mul_i32 exec_lo, s64, 0xffff
    s_mul_i32 exec_hi, s65, 0xffff
    buffer_load_dword v48, v88, s[32:35], s8 offen sc1
    buffer_load_dword v49, v105, s[36:39], s72 offen offset:512 sc1
    s_lshr_b64 s[64:65], s[70:71], 2
    s_and_b64 s[64:65], s[64:65], s[94:95]
    s_mul_i32 exec_lo, s64, 0xffff
    s_mul_i32 exec_hi, s65, 0xffff
    buffer_load_dword v50, v88, s[32:35], s9 offen sc1
    buffer_load_dword v51, v105, s[36:39], s73 offen offset:512 sc1
    s_lshr_b64 s[64:65], s[16:17], 3
    s_and_b64 s[64:65], s[64:65], s[94:95]
    s_mul_i32 exec_lo, s64, 0xffff
    s_mul_i32 exec_hi, s65, 0xffff
    buffer_load_dword v52, v88, s[32:35], s10 offen sc1
    buffer_load_dword v53, v105, s[36:39], s72 offen offset:768 sc1
    s_and_b64 exec, s[64:65], s[84:85]
    buffer_load_dwordx2 v[72:73], v106, s[32:35], s74 offen offset:0 sc1
    s_lshr_b64 s[64:65], s[70:71], 3
    s_and_b64 s[64:65], s[64:65], s[94:95]
    s_mul_i32 exec_lo, s64, 0xffff
    s_mul_i32 exec_hi, s65, 0xffff
    buffer_load_dword v54, v88, s[32:35], s11 offen sc1
    buffer_load_dword v55, v105, s[36:39], s73 offen offset:768 sc1
    s_and_b64 exec, s[64:65], s[84:85]
    buffer_load_dwordx2 v[74:75], v106, s[32:35], s74 offen offset:64 sc1
    s_or_b64 s[64:65], s[12:13], s[14:15]
    s_cbranch_scc0 L_prog_done
L_prog_idle:
    s_sleep 2
    s_mov_b64 exec, -1
    ds_read_b64 v[80:81], v82 offset:49280
    s_cmp_lt_u32 s93, 0x400000
    s_cbranch_scc1 L_prog
L_prog_done:
    s_mov_b64 exec, -1
    s_waitcnt vmcnt(0)
    v_mfma_f32_16x16x32_bf16 v[84:87], v[100:103], v[72:75], 0
    v_mfma_f32_16x16x32_bf16 v[56:59], v[100:103], v[40:43], 0
    s_mov_b64 exec, s[84:85]
    s_nop 5
    v_add_f32 v84, v84, v86
    v_mul_f32 v84, 0.5, v84
    v_add_f32 v85, v85, v87
    v_mul_f32 v85, 0.5, v85
    v_cvt_pk_bf16_f32 v80, v84, v85
    ds_write_b32 v104, v80 offset:512
    s_mov_b64 exec, s[82:83]
    v_add_f32 v56, v56, v58
    v_mul_f32 v56, 0.5, v56
    v_add_f32 v57, v57, v59
    v_mul_f32 v57, 0.5, v57
    s_mov_b64 exec, -1
    s_waitcnt vmcnt(0)
    v_mfma_f32_16x16x32_bf16 v[60:63], v[100:103], v[44:47], 0
    v_cvt_pk_bf16_f32 v72, v56, v57
    v_cvt_pk_bf16_f32 v79, v58, v59
    s_waitcnt vmcnt(0)
    v_mfma_f32_16x16x32_bf16 v[64:67], v[100:103], v[48:51], 0
    s_nop 3
    v_cvt_pk_bf16_f32 v73, v60, v61
    v_cvt_pk_bf16_f32 v78, v62, v63
    s_waitcnt vmcnt(0)
    v_mfma_f32_16x16x32_bf16 v[68:71], v[100:103], v[52:55], 0
    v_cvt_pk_bf16_f32 v74, v64, v65
    v_cvt_pk_bf16_f32 v77, v66, v67
    s_nop 5
    v_cvt_pk_bf16_f32 v75, v68, v69
    v_cvt_pk_bf16_f32 v76, v70, v71
    ds_write_b128 v90, v[72:75]
    ds_write_b128 v91, v[76:79]
    s_mov_b64 exec, s[80:81]
    ds_write2_b32 v92, v76, v77 offset0:1 offset1:2
    ds_write_b32 v92, v78 offset:12
    s_andn2_b64 exec, s[80:81], s[82:83]
    ds_write_b32 v92, v79 offset:256
    s_mov_b64 exec, -1
    s_waitcnt lgkmcnt(0)
    s_barrier
    ds_read_b128 v[40:43], v98 offset:0
    ds_read_b128 v[44:47], v98 offset:1024
    ds_read_b128 v[48:51], v99 offset:2048
    ds_read_b128 v[52:55], v99 offset:3072
    s_waitcnt lgkmcnt(3)
    v_mfma_f32_16x16x32_bf16 v[56:59], v[40:43], v[8:11], 0
    v_mfma_f32_16x16x32_bf16 v[60:63], v[40:43], v[16:19], 0
    s_waitcnt lgkmcnt(2)
    v_mfma_f32_16x16x32_bf16 v[56:59], v[44:47], v[12:15], v[56:59]
    v_mfma_f32_16x16x32_bf16 v[60:63], v[44:47], v[20:23], v[60:63]
    s_waitcnt lgkmcnt(1)
    v_mfma_f32_16x16x32_bf16 v[64:67], v[48:51], v[8:11], 0
    v_mfma_f32_16x16x32_bf16 v[68:71], v[48:51], v[16:19], 0
    s_waitcnt lgkmcnt(0)
    v_mfma_f32_16x16x32_bf16 v[64:67], v[52:55], v[12:15], v[64:67]
    v_mfma_f32_16x16x32_bf16 v[68:71], v[52:55], v[20:23], v[68:71]
    s_nop 1
    v_pk_mul_f32 v[80:81], v[60:61], v[32:33]
    v_pk_mul_f32 v[82:83], v[56:57], v[32:33]
    v_pk_fma_f32 v[80:81], v[56:57], v[24:25], v[80:81]
    v_pk_fma_f32 v[82:83], v[60:61], v[24:25], v[82:83] neg_lo:[0,0,1] neg_hi:[0,0,1]
    v_cvt_pk_bf16_f32 v72, v80, v82
    v_cvt_pk_bf16_f32 v76, v81, v83
    v_pk_mul_f32 v[84:85], v[62:63], v[34:35]
    v_pk_mul_f32 v[86:87], v[58:59], v[34:35]
    v_pk_fma_f32 v[84:85], v[58:59], v[26:27], v[84:85]
    v_pk_fma_f32 v[86:87], v[62:63], v[26:27], v[86:87] neg_lo:[0,0,1] neg_hi:[0,0,1]
    v_cvt_pk_bf16_f32 v73, v84, v86
    v_cvt_pk_bf16_f32 v77, v85, v87
    v_pk_mul_f32 v[80:81], v[68:69], v[36:37]
    v_pk_mul_f32 v[82:83], v[64:65], v[36:37]
    v_pk_fma_f32 v[80:81], v[64:65], v[28:29], v[80:81]
    v_pk_fma_f32 v[82:83], v[68:69], v[28:29], v[82:83] neg_lo:[0,0,1] neg_hi:[0,0,1]
    v_cvt_pk_bf16_f32 v74, v80, v82
    v_cvt_pk_bf16_f32 v78, v81, v83
    v_pk_mul_f32 v[84:85], v[70:71], v[38:39]
    v_pk_mul_f32 v[86:87], v[66:67], v[38:39]
    v_pk_fma_f32 v[84:85], v[66:67], v[30:31], v[84:85]
    v_pk_fma_f32 v[86:87], v[70:71], v[30:31], v[86:87] neg_lo:[0,0,1] neg_hi:[0,0,1]
    v_cvt_pk_bf16_f32 v75, v84, v86
    v_cvt_pk_bf16_f32 v79, v85, v87
    s_nop 0
    v_mfma_f32_16x16x32_bf16 v[40:43], v[72:75], v[8:11], 0
    v_mfma_f32_16x16x32_bf16 v[48:51], v[76:79], v[12:15], 0
    v_mfma_f32_16x16x32_bf16 v[44:47], v[72:75], v[16:19], 0
    v_mfma_f32_16x16x32_bf16 v[52:55], v[76:79], v[20:23], 0
    s_nop 5
    v_pk_fma_f32 v[56:57], v[48:49], s[90:91], v[40:41]
    v_pk_fma_f32 v[64:65], v[48:49], s[90:91], v[40:41] neg_lo:[1,0,0] neg_hi:[1,0,0]
    v_pk_fma_f32 v[58:59], v[50:51], s[90:91], v[42:43]
    v_pk_fma_f32 v[66:67], v[50:51], s[90:91], v[42:43] neg_lo:[1,0,0] neg_hi:[1,0,0]
    v_pk_fma_f32 v[60:61], v[52:53], s[90:91], v[44:45]
    v_pk_fma_f32 v[68:69], v[52:53], s[90:91], v[44:45] neg_lo:[1,0,0] neg_hi:[1,0,0]
    v_pk_fma_f32 v[62:63], v[54:55], s[90:91], v[46:47]
    v_pk_fma_f32 v[70:71], v[54:55], s[90:91], v[46:47] neg_lo:[1,0,0] neg_hi:[1,0,0]
    v_cvt_pk_bf16_f32 v72, v56, v57
    v_cvt_pk_bf16_f32 v73, v58, v59
    ds_write_b64 v107, v[72:73] offset:32768
    v_cvt_pk_bf16_f32 v74, v64, v65
    v_cvt_pk_bf16_f32 v75, v66, v67
    ds_write_b64 v107, v[74:75] offset:33792
    v_cvt_pk_bf16_f32 v76, v60, v61
    v_cvt_pk_bf16_f32 v77, v62, v63
    ds_write_b64 v107, v[76:77] offset:40960
    v_cvt_pk_bf16_f32 v78, v68, v69
    v_cvt_pk_bf16_f32 v79, v70, v71
    ds_write_b64 v107, v[78:79] offset:41984
    s_waitcnt lgkmcnt(0)
    s_barrier
    ds_read_b128 v[40:43], v108 offset:32768
    ds_read_b128 v[44:47], v108 offset:33792
    s_waitcnt lgkmcnt(1)
    buffer_store_dwordx4 v[40:43], v109, s[36:39], s78 offen offset:0 sc1
    s_waitcnt lgkmcnt(0)
    buffer_store_dwordx4 v[44:47], v109, s[36:39], s78 offen offset:1024 sc1
    s_endpgm
    s_nop 0
L_nonce_slow:
    s_mov_b32 s64, 0
L_nonce1:
    v_readfirstlane_b32 s3, v5
    s_nop 3
    s_cmp_lg_u32 s3, 0
    s_cbranch_scc1 L_nonce1_ok
    s_sleep 2
    buffer_load_dword v5, v4, s[40:43], 0 offen sc0 sc1
    s_add_u32 s64, s64, 1
    s_waitcnt vmcnt(0)
    s_cmp_lt_u32 s64, 0x40000
    s_cbranch_scc1 L_nonce1
L_nonce1_ok:
    s_branch L_nonce_ret
L_spA:
    v_lshlrev_b32 v93, 12, v3
    v_lshl_add_u32 v93, v2, 6, v93
    s_lshl_b32 s80, s66, 2
    s_add_u32 s80, s80, 4194304
    v_and_b32 v95, 7, v2
    v_lshlrev_b32 v94, 3, v95
    v_lshrrev_b32 v95, 3, v2
    v_lshl_add_u32 v94, v95, 9, v94
    v_lshl_add_u32 v94, v3, 12, v94
    s_lshl_b32 s81, s66, 6
    s_add_u32 s81, s81, 0x420000
    buffer_load_dword v96, v93, s[32:35], s80 offen offset:0 sc1
    buffer_load_dword v97, v93, s[32:35], s80 offen offset:1024 sc1
    buffer_load_dword v98, v93, s[32:35], s80 offen offset:2048 sc1
    buffer_load_dword v99, v93, s[32:35], s80 offen offset:3072 sc1
    buffer_load_dwordx2 v[100:101], v94, s[32:35], s81 offen offset:0 sc1
    buffer_load_dwordx2 v[102:103], v94, s[32:35], s81 offen offset:1024 sc1
    buffer_load_dwordx2 v[104:105], v94, s[32:35], s81 offen offset:2048 sc1
    buffer_load_dwordx2 v[106:107], v94, s[32:35], s81 offen offset:3072 sc1
    s_branch L_spA_ret
L_spB:
    s_setprio 3
    v_cvt_f32_u32 v8, v2
    v_lshlrev_b32 v9, 2, v3
    v_cvt_f32_u32 v9, v9
    v_mul_f32 v8, 0x3b800000, v8
    v_mul_f32 v36, v9, v8
    v_fmamk_f32 v37, v8, 0x3f800000, v36
    v_fmamk_f32 v38, v8, 0x40000000, v36
    v_fmamk_f32 v39, v8, 0x40400000, v36
    v_cos_f32 v32, v36
    v_sin_f32 v36, v36
    v_cos_f32 v33, v37
    v_sin_f32 v37, v37
    v_cos_f32 v34, v38
    v_sin_f32 v38, v38
    v_cos_f32 v35, v39
    v_sin_f32 v39, v39
    s_cmp_eq_u32 s83, 2
    s_nop 0
    s_cbranch_scc1 L_spB_nw
    s_waitcnt vmcnt(2)
L_spB_nw:
    v_mfma_f32_16x16x32_bf16 v[56:59], v[96:99], v[16:19], 0
    v_mfma_f32_16x16x32_bf16 v[60:63], v[96:99], v[20:23], 0
    s_nop 7
    v_pk_mul_f32 v[8:9], v[60:61], v[36:37]
    v_pk_mul_f32 v[10:11], v[56:57], v[36:37]
    v_pk_fma_f32 v[8:9], v[56:57], v[32:33], v[8:9]
    v_pk_fma_f32 v[10:11], v[60:61], v[32:33], v[10:11] neg_lo:[0,0,1] neg_hi:[0,0,1]
    v_cvt_pk_bf16_f32 v84, v8, v10
    v_cvt_pk_bf16_f32 v85, v9, v11
    v_pk_mul_f32 v[12:13], v[62:63], v[38:39]
    v_pk_mul_f32 v[14:15], v[58:59], v[38:39]
    v_pk_fma_f32 v[12:13], v[58:59], v[34:35], v[12:13]
    v_pk_fma_f32 v[14:15], v[62:63], v[34:35], v[14:15] neg_lo:[0,0,1] neg_hi:[0,0,1]
    v_cvt_pk_bf16_f32 v86, v12, v14
    v_cvt_pk_bf16_f32 v87, v13, v15
    s_nop 1
    v_mfma_f32_16x16x32_bf16 v[64:67], v[16:19], v[84:87], 0
    v_mfma_f32_16x16x32_bf16 v[68:71], v[20:23], v[84:87], 0
    v_lshlrev_b32 v56, 16, v100
    v_and_b32 v60, 0xffff0000, v100
    v_lshlrev_b32 v57, 16, v102
    v_and_b32 v61, 0xffff0000, v102
    v_lshlrev_b32 v58, 16, v104
    v_and_b32 v62, 0xffff0000, v104
    v_lshlrev_b32 v59, 16, v106
    v_and_b32 v63, 0xffff0000, v106
    v_pk_mul_f32 v[8:9], v[68:69], v[60:61]
    v_pk_mul_f32 v[10:11], v[68:69], v[56:57]
    v_pk_fma_f32 v[8:9], v[64:65], v[56:57], v[8:9] neg_lo:[0,0,1] neg_hi:[0,0,1]
    v_pk_fma_f32 v[10:11], v[64:65], v[60:61], v[10:11] neg_lo:[1,0,1] neg_hi:[1,0,1]
    v_cvt_pk_bf16_f32 v72, v8, v10
    v_cvt_pk_bf16_f32 v73, v9, v11
    v_pk_mul_f32 v[12:13], v[70:71], v[62:63]
    v_pk_mul_f32 v[14:15], v[70:71], v[58:59]
    v_pk_fma_f32 v[12:13], v[66:67], v[58:59], v[12:13] neg_lo:[0,0,1] neg_hi:[0,0,1]
    v_pk_fma_f32 v[14:15], v[66:67], v[62:63], v[14:15] neg_lo:[1,0,1] neg_hi:[1,0,1]
    v_cvt_pk_bf16_f32 v74, v12, v14
    v_cvt_pk_bf16_f32 v75, v13, v15
    v_lshlrev_b32 v56, 16, v101
    v_and_b32 v60, 0xffff0000, v101
    v_lshlrev_b32 v57, 16, v103
    v_and_b32 v61, 0xffff0000, v103
    v_lshlrev_b32 v58, 16, v105
    v_and_b32 v62, 0xffff0000, v105
    v_lshlrev_b32 v59, 16, v107
    v_and_b32 v63, 0xffff0000, v107
    v_pk_mul_f32 v[8:9], v[68:69], v[60:61]
    v_pk_mul_f32 v[10:11], v[68:69], v[56:57]
    v_pk_fma_f32 v[8:9], v[64:65], v[56:57], v[8:9] neg_lo:[0,0,1] neg_hi:[0,0,1]
    v_pk_fma_f32 v[10:11], v[64:65], v[60:61], v[10:11] neg_lo:[1,0,1] neg_hi:[1,0,1]
    v_cvt_pk_bf16_f32 v84, v8, v10
    v_cvt_pk_bf16_f32 v85, v9, v11
    v_pk_mul_f32 v[12:13], v[70:71], v[62:63]
    v_pk_mul_f32 v[14:15], v[70:71], v[58:59]
    v_pk_fma_f32 v[12:13], v[66:67], v[58:59], v[12:13] neg_lo:[0,0,1] neg_hi:[0,0,1]
    v_pk_fma_f32 v[14:15], v[66:67], v[62:63], v[14:15] neg_lo:[1,0,1] neg_hi:[1,0,1]
    v_cvt_pk_bf16_f32 v86, v12, v14
    v_cvt_pk_bf16_f32 v87, v13, v15
    v_mfma_f32_16x16x32_bf16 v[56:59], v[72:75], v[16:19], 0
    v_mfma_f32_16x16x32_bf16 v[60:63], v[72:75], v[20:23], 0
    v_mfma_f32_16x16x32_bf16 v[64:67], v[84:87], v[16:19], 0
    v_mfma_f32_16x16x32_bf16 v[68:71], v[84:87], v[20:23], 0
    s_nop 5
    v_pk_mul_f32 v[8:9], v[60:61], v[36:37]
    v_pk_mul_f32 v[10:11], v[56:57], v[36:37]
    v_pk_fma_f32 v[8:9], v[56:57], v[32:33], v[8:9]
    v_pk_fma_f32 v[10:11], v[60:61], v[32:33], v[10:11] neg_lo:[0,0,1] neg_hi:[0,0,1]
    v_cvt_pk_bf16_f32 v72, v8, v10
    v_cvt_pk_bf16_f32 v73, v9, v11
    v_pk_mul_f32 v[12:13], v[62:63], v[38:39]
    v_pk_mul_f32 v[14:15], v[58:59], v[38:39]
    v_pk_fma_f32 v[12:13], v[58:59], v[34:35], v[12:13]
    v_pk_fma_f32 v[14:15], v[62:63], v[34:35], v[14:15] neg_lo:[0,0,1] neg_hi:[0,0,1]
    v_cvt_pk_bf16_f32 v74, v12, v14
    v_cvt_pk_bf16_f32 v75, v13, v15
    s_nop 1
    v_mfma_f32_16x16x32_bf16 v[76:79], v[16:19], v[72:75], 0
    v_mfma_f32_16x16x32_bf16 v[80:83], v[20:23], v[72:75], 0
    v_pk_mul_f32 v[8:9], v[68:69], v[36:37]
    v_pk_mul_f32 v[10:11], v[64:65], v[36:37]
    v_pk_fma_f32 v[8:9], v[64:65], v[32:33], v[8:9]
    v_pk_fma_f32 v[10:11], v[68:69], v[32:33], v[10:11] neg_lo:[0,0,1] neg_hi:[0,0,1]
    v_cvt_pk_bf16_f32 v84, v8, v10
    v_cvt_pk_bf16_f32 v85, v9, v11
    v_pk_mul_f32 v[12:13], v[70:71], v[38:39]
    v_pk_mul_f32 v[14:15], v[66:67], v[38:39]
    v_pk_fma_f32 v[12:13], v[66:67], v[34:35], v[12:13]
    v_pk_fma_f32 v[14:15], v[70:71], v[34:35], v[14:15] neg_lo:[0,0,1] neg_hi:[0,0,1]
    v_cvt_pk_bf16_f32 v86, v12, v14
    v_cvt_pk_bf16_f32 v87, v13, v15
    s_nop 1
    v_mfma_f32_16x16x32_bf16 v[56:59], v[16:19], v[84:87], 0
    v_mfma_f32_16x16x32_bf16 v[60:63], v[20:23], v[84:87], 0
    v_cvt_pk_bf16_f32 v64, v76, v80
    s_nop 6
    v_cvt_pk_bf16_f32 v65, v56, v60
    v_cvt_pk_bf16_f32 v66, v77, v81
    v_cvt_pk_bf16_f32 v67, v57, v61
    v_cvt_pk_bf16_f32 v68, v78, v82
    v_cvt_pk_bf16_f32 v69, v58, v62
    v_cvt_pk_bf16_f32 v70, v79, v83
    v_cvt_pk_bf16_f32 v71, v59, v63
    s_setprio 0
    s_cmp_eq_u32 s83, 2
    s_cbranch_scc1 L_spD_ret
    buffer_store_dwordx2 v[64:65], v94, s[32:35], s81 offen offset:0 sc1
    buffer_store_dwordx2 v[66:67], v94, s[32:35], s81 offen offset:1024 sc1
    buffer_store_dwordx2 v[68:69], v94, s[32:35], s81 offen offset:2048 sc1
    buffer_store_dwordx2 v[70:71], v94, s[32:35], s81 offen offset:3072 sc1
    s_branch L_spB_ret
L_end:
    s_endpgm
L_codeend:
.section .rodata,"a"
.p2align 6
.amdhsa_kernel gated_mix__spectral_gfnet__spectral_gfnet__prompt_kernel
  .amdhsa_next_free_vgpr 128
  .amdhsa_next_free_sgpr 102
  .amdhsa_accum_offset 128
  .amdhsa_group_segment_fixed_size 0
  .amdhsa_kernarg_size 80
  .amdhsa_user_sgpr_count 2
  .amdhsa_user_sgpr_kernarg_segment_ptr 1
  .amdhsa_system_sgpr_workgroup_id_x 1
.end_amdhsa_kernel
```
